```python
import torch

def _softmax(x, axis=-1):
    return torch.softmax(x, dim=axis)
def _gelu(x):
    return torch.nn.functional.gelu(x, approximate="tanh")
def _silu(x):
    return torch.nn.functional.silu(x)
def _sigmoid(x):
    return torch.sigmoid(x)
def _layernorm(x, axis=-1, eps=1e-5):
    m = x.mean(dim=axis, keepdim=True)
    v = x.var(dim=axis, keepdim=True, unbiased=False)
    return (x - m) / torch.sqrt(v + eps)
def _scatter_add(tgt, idx, src, axis=0):
    return tgt.clone().index_add_(axis, idx, src)
def _segment_sum(src, seg, n):
    out = torch.zeros((n,) + src.shape[1:], dtype=src.dtype)
    return out.index_add_(0, seg, src)
def _pad(x, pw):
    flat = tuple(v for pair in reversed(pw) for v in pair)
    return torch.nn.functional.pad(x, flat)

kernel_name = 'concat_heads__sliding_block_cached__sliding_block_cached__decode'

def setup_inputs():

    _w = (lambda a: (lambda t: t.to(torch.bfloat16) if t.is_floating_point() else t)(torch.as_tensor(a)))
    def _A_setup():
        B, Sq, D = 8, 1, 512
        Hq, Hkv, Sk, Dh = 32, 8, 8192, 128
        assert Hq % Hkv == 0, (Hq, Hkv)
        return {
            "x": _w((lambda *s: torch.randn(*s, dtype=torch.bfloat16) * 0.8)(B, Sq, D)),
            "k_cache": _w((lambda *s: torch.randn(*s, dtype=torch.bfloat16) * 0.8)(B, Hkv, Sk, Dh)),
            "v_cache": _w((lambda *s: torch.randn(*s, dtype=torch.bfloat16) * 0.05)(B, Hkv, Sk, Dh)),
            "wq": _w((lambda *s: torch.randn(*s, dtype=torch.bfloat16) * 0.8)(D, Hq * Dh) * (D ** -0.5)),
            "wo": _w((lambda *s: torch.randn(*s, dtype=torch.bfloat16) * 0.05)(Hq * Dh, D) * ((Hq * Dh) ** -0.5)),
        }
    _A_in = _A_setup()

    def _B_setup():
        B, Sq, D = 8, 1, 512
        Hq, Hkv, Sk, Dh = 32, 8, 8192, 128
        assert Hq % Hkv == 0, (Hq, Hkv)
        return {
            "x": _w((lambda *s: torch.randn(*s, dtype=torch.bfloat16) * 0.8)(B, Sq, D)),
            "k_cache": _w((lambda *s: torch.randn(*s, dtype=torch.bfloat16) * 0.8)(B, Hkv, Sk, Dh)),
            "v_cache": _w((lambda *s: torch.randn(*s, dtype=torch.bfloat16) * 0.05)(B, Hkv, Sk, Dh)),
            "wq": _w((lambda *s: torch.randn(*s, dtype=torch.bfloat16) * 0.8)(D, Hq * Dh) * (D ** -0.5)),
            "wo": _w((lambda *s: torch.randn(*s, dtype=torch.bfloat16) * 0.05)(Hq * Dh, D) * ((Hq * Dh) ** -0.5)),
        }
    _B_in = _B_setup()

    return {
        "A_x": _A_in["x"],
        "A_k_cache": _A_in["k_cache"],
        "A_v_cache": _A_in["v_cache"],
        "A_wq": _A_in["wq"],
        "A_wo": _A_in["wo"],
        "B_x": _B_in["x"],
        "B_k_cache": _B_in["k_cache"],
        "B_v_cache": _B_in["v_cache"],
        "B_wq": _B_in["wq"],
        "B_wo": _B_in["wo"],
    }

def reference(A_x, A_k_cache, A_v_cache, A_wq, A_wo, B_x, B_k_cache, B_v_cache, B_wq, B_wo):
    def _A_ref(x, k_cache, v_cache, wq, wo):
        B, Sq, D = x.shape
        Hq, Dh = 32, 128
        Hkv, Sk = k_cache.shape[1], k_cache.shape[2]
        W = min(4096, max(256, Sk // 4))
        rep = Hq // Hkv
        q = (lambda x, *d: x.permute(*d))((x @ wq).reshape(B, Sq, Hq, Dh), 0, 2, 1, 3)
        k = (lambda x, n, axis: torch.repeat_interleave(x, n, dim=axis))(k_cache[:, :, Sk - W:, :], rep, axis=1)
        v = (lambda x, n, axis: torch.repeat_interleave(x, n, dim=axis))(v_cache[:, :, Sk - W:, :], rep, axis=1)
        scores = torch.einsum("bhqd,bhkd->bhqk", q, k) * (Dh ** -0.5)
        p = _softmax(scores, axis=-1)
        o = torch.einsum("bhqk,bhkd->bhqd", p, v)
        return (lambda x, *d: x.permute(*d))(o, 0, 2, 1, 3).reshape(B, Sq, Hq * Dh) @ wo

    def _B_ref(x, k_cache, v_cache, wq, wo):
        B, Sq, D = x.shape
        Hq, Dh = 32, 128
        Hkv, Sk = k_cache.shape[1], k_cache.shape[2]
        W = min(4096, max(256, Sk // 4))
        rep = Hq // Hkv
        q = (lambda x, *d: x.permute(*d))((x @ wq).reshape(B, Sq, Hq, Dh), 0, 2, 1, 3)
        k = (lambda x, n, axis: torch.repeat_interleave(x, n, dim=axis))(k_cache[:, :, Sk - W:, :], rep, axis=1)
        v = (lambda x, n, axis: torch.repeat_interleave(x, n, dim=axis))(v_cache[:, :, Sk - W:, :], rep, axis=1)
        scores = torch.einsum("bhqd,bhkd->bhqk", q, k) * (Dh ** -0.5)
        p = _softmax(scores, axis=-1)
        o = torch.einsum("bhqk,bhkd->bhqd", p, v)
        return (lambda x, *d: x.permute(*d))(o, 0, 2, 1, 3).reshape(B, Sq, Hq * Dh) @ wo

    a = _A_ref(A_x, A_k_cache, A_v_cache, A_wq, A_wo)
    b = _B_ref(B_x, B_k_cache, B_v_cache, B_wq, B_wo)
    return torch.concatenate([a, b], axis=-1)
```

```asm
; @launch grid=(256,1,1) block=(512,1,1) lds=153600
.amdgcn_target "amdgcn-amd-amdhsa--gfx950"
.text
.globl concat_heads__sliding_block_cached__sliding_block_cached__decode_kernel
.p2align 8
.type concat_heads__sliding_block_cached__sliding_block_cached__decode_kernel,@function
concat_heads__sliding_block_cached__sliding_block_cached__decode_kernel:
    s_bfe_u32 s4, s2, 0x10002
    s_mul_i32 s5, s4, 40
    s_add_u32 s6, s0, s5
    s_addc_u32 s7, s1, 0
    s_load_dwordx2 s[36:37], s[6:7], 24
    v_lshrrev_b32 v8, 6, v0
    v_bfe_u32 v7, v0, 3, 3
    v_readfirstlane_b32 s13, v8
    s_cmpk_ge_u32 s2, 256
    s_cbranch_scc1 L_end
    v_lshlrev_b32 v7, 13, v7
    v_and_b32 v6, 7, v0
    v_lshl_or_b32 v7, v6, 4, v7
    s_and_b32 s5, s2, 3
    s_lshr_b32 s22, s2, 1
    s_and_b32 s22, s22, 4
    s_or_b32 s5, s5, s22
    s_lshr_b32 s8, s2, 4
    s_and_b32 s9, s8, 7
    s_and_b32 s23, s8, 8
    s_add_u32 s23, s23, s13
    s_lshl_b32 s60, s23, 8
    s_add_u32 s60, s60, s5
    s_lshl_b32 s60, s60, 3
    s_add_u32 s60, s60, s9
    s_lshl_b32 s60, s60, 7
    s_mov_b32 s61, 0x20000
    s_mov_b32 s38, 0x400000
    s_mov_b32 s39, s61
    s_lshl_b32 s24, s13, 12
    s_mov_b32 m0, s24
    s_waitcnt lgkmcnt(0)
    buffer_load_dwordx4 v7, s[36:39], s60 offen nt lds
    s_add_u32 m0, s24, 1024
    s_add_u32 s60, s60, 0x10000
    buffer_load_dwordx4 v7, s[36:39], s60 offen nt lds
    s_add_u32 m0, s24, 2048
    s_add_u32 s60, s60, 0x10000
    buffer_load_dwordx4 v7, s[36:39], s60 offen nt lds
    s_add_u32 m0, s24, 3072
    s_add_u32 s60, s60, 0x10000
    buffer_load_dwordx4 v7, s[36:39], s60 offen nt lds
    s_load_dwordx2 s[28:29], s[6:7], 8
    s_load_dwordx2 s[44:45], s[6:7], 0
    s_load_dwordx2 s[48:49], s[0:1], 96
    s_load_dwordx2 s[32:33], s[6:7], 16
    s_load_dwordx2 s[40:41], s[6:7], 32
    s_load_dwordx2 s[52:53], s[0:1], 80
    s_load_dwordx2 s[56:57], s[0:1], 88
    v_and_b32 v1, 63, v0
    v_and_b32 v2, 15, v0
    v_bfe_u32 v3, v0, 4, 2
    s_lshr_b32 s10, s8, 3
    s_mov_b32 s30, 0x8000000
    s_mov_b32 s31, s61
    v_lshlrev_b32 v80, 2, v3
    v_xor_b32 v80, v80, v2
    v_lshlrev_b32 v80, 4, v80
    v_lshl_or_b32 v80, v3, 8, v80
    v_xor_b32 v81, 16, v80
    v_xor_b32 v82, 32, v80
    v_xor_b32 v83, 48, v80
    s_mul_i32 s100, s13, 12288
    s_add_u32 s100, s100, 55296
    s_lshl_b32 s14, s9, 3
    s_add_u32 s14, s14, s5
    s_lshl_b32 s14, s14, 21
    s_lshl_b32 s22, s10, 15
    s_add_u32 s14, s14, s22
    s_add_u32 s14, s14, s24
    s_add_u32 s14, s14, 1572864
    s_lshl_b32 s3, s4, 3
    s_or_b32 s3, s3, s5
    s_mov_b32 s46, 0x2000
    s_mov_b32 s47, s61
    s_mov_b32 s50, 0x21004000
    s_mov_b32 s51, s61
    s_mov_b32 s34, 0x8000000
    s_mov_b32 s35, s61
    s_mov_b32 s42, 0x400000
    s_mov_b32 s43, s61
    s_mov_b32 s54, 0x4000
    s_mov_b32 s55, s61
    s_mov_b32 s58, 0x100
    s_mov_b32 s59, s61
    v_lshlrev_b32 v6, 10, v6
    v_lshl_or_b32 v6, v3, 4, v6
    s_lshl_b32 s23, s23, 6
    s_waitcnt lgkmcnt(0)
    buffer_load_dwordx4 v[32:35], v6, s[44:47], s23 offen
    v_lshlrev_b32 v5, 4, v1
    s_xor_b32 s101, s9, 4
    s_lshl_b32 s21, s5, 1
    s_add_u32 s21, s21, s10
    s_lshl_b32 s97, s4, 3
    s_add_u32 s97, s97, s101
    s_lshl_b32 s97, s97, 15
    s_lshl_b32 s20, s21, 11
    s_add_u32 s20, s20, s97
    s_lshl_b32 s98, s3, 16
    s_add_u32 s98, s98, 1048576
    s_cmp_lg_u32 s13, 3
    s_cbranch_scc1 L_1
    v_mov_b32 v12, -1
    v_mov_b32 v13, -1
    v_mov_b32 v14, -1
    v_mov_b32 v15, -1
    s_lshl_b32 s22, s8, 10
    s_add_u32 s22, s22, s98
    s_add_u32 s22, s22, 32768
    buffer_store_dwordx4 v[12:15], v5, s[48:51], s22 offen
    s_lshl_b32 s22, s8, 4
    s_add_u32 s22, s22, s98
    s_add_u32 s22, s22, 49152
    s_mov_b64 exec, 1
    buffer_store_dwordx4 v[12:15], off, s[48:51], s22
    s_mov_b64 exec, -1
L_1:
    s_getreg_b32 s11, hwreg(HW_REG_XCC_ID, 0, 3)
    v_mov_b32 v10, 0
    v_mov_b32 v11, 0
    v_mov_b32 v16, 50432
    ds_write2_b64 v16, v[10:11], v[10:11] offset0:0 offset1:1
    ds_write_b64 v16, v[10:11] offset:16
    s_mov_b32 s12, 3
    s_mov_b32 s16, 0x05040100
    s_mov_b32 s17, 0x07060302
    s_mov_b32 s18, 0x3e0293ee
    s_mov_b32 s62, 0xff00ff00
    s_mov_b32 s63, s62
    s_lshl_b32 s96, s4, 7
    s_add_u32 s96, s96, 3149824
    s_waitcnt lgkmcnt(0)
    s_barrier
    s_load_dwordx2 s[6:7], s[48:49], s96
    v_and_b32 v9, 3, v0
    v_bfe_u32 v8, v0, 2, 2
    v_xor_b32 v84, v3, v2
    v_lshlrev_b32 v84, 4, v84
    v_lshl_or_b32 v84, v9, 10, v84
    v_lshl_or_b32 v84, v8, 8, v84
    v_xor_b32 v85, 64, v84
    v_xor_b32 v86, 128, v84
    v_xor_b32 v87, 192, v84
    v_add_u32 v84, s100, v84
    v_add_u32 v85, s100, v85
    v_add_u32 v86, s100, v86
    v_add_u32 v87, s100, v87
    v_lshlrev_b32 v10, 10, v3
    v_lshl_or_b32 v10, v8, 7, v10
    v_lshl_or_b32 v10, v9, 3, v10
    v_add_u32 v10, s24, v10
    s_lshl_b32 s22, s13, 11
    v_add_u32 v11, s22, v5
    v_and_b32 v4, 7, v2
    v_lshlrev_b32 v4, 12, v4
    v_lshrrev_b32 v9, 3, v2
    v_lshl_or_b32 v4, v9, 6, v4
    v_lshl_or_b32 v4, v3, 4, v4
    s_mov_b32 s15, s14
    s_mov_b32 m0, s100
    s_waitcnt vmcnt(3)
    buffer_load_dwordx4 v80, s[28:31], s15 offen offset:0 nt lds
    s_waitcnt vmcnt(3)
    buffer_load_dwordx4 v81, s[28:31], s15 offen offset:1024 nt lds
    s_waitcnt vmcnt(3)
    buffer_load_dwordx4 v82, s[28:31], s15 offen offset:2048 nt lds
    s_waitcnt vmcnt(2)
    buffer_load_dwordx4 v83, s[28:31], s15 offen offset:3072 nt lds
    s_add_u32 s15, s14, 65536
    s_add_u32 m0, s100, 4096
    s_waitcnt vmcnt(2)
    buffer_load_dwordx4 v80, s[28:31], s15 offen offset:0 nt lds
    s_waitcnt vmcnt(2)
    buffer_load_dwordx4 v81, s[28:31], s15 offen offset:1024 nt lds
    s_waitcnt vmcnt(2)
    buffer_load_dwordx4 v82, s[28:31], s15 offen offset:2048 nt lds
    s_waitcnt vmcnt(2)
    buffer_load_dwordx4 v83, s[28:31], s15 offen offset:3072 nt lds
    s_waitcnt vmcnt(8)
    ds_read_b64_tr_b16 v[16:17], v10 offset:0
    ds_read_b64_tr_b16 v[18:19], v10 offset:512
    ds_read_b64_tr_b16 v[20:21], v10 offset:32
    ds_read_b64_tr_b16 v[22:23], v10 offset:544
    ds_read_b64_tr_b16 v[24:25], v10 offset:64
    ds_read_b64_tr_b16 v[26:27], v10 offset:576
    ds_read_b64_tr_b16 v[28:29], v10 offset:96
    ds_read_b64_tr_b16 v[30:31], v10 offset:608
    v_mov_b32 v13, 50436
    v_mov_b32 v14, 1
    s_waitcnt lgkmcnt(0)
    v_mfma_f32_16x16x32_bf16 v[40:43], v[16:19], v[32:35], 0
    v_mfma_f32_16x16x32_bf16 v[44:47], v[20:23], v[32:35], 0
    v_mfma_f32_16x16x32_bf16 v[48:51], v[24:27], v[32:35], 0
    v_mfma_f32_16x16x32_bf16 v[52:55], v[28:31], v[32:35], 0
    s_mul_i32 s6, s6, 0x9e3779b5
    s_add_u32 s6, s6, 0x7f4a7c15
    s_mul_i32 s7, s7, 0x85ebca6d
    s_add_u32 s7, s7, 0x165667b1
    s_nop 1
    v_cndmask_b32 v40, v40, v44, s[62:63]
    v_cndmask_b32 v41, v41, v45, s[62:63]
    v_cndmask_b32 v42, v42, v46, s[62:63]
    v_cndmask_b32 v43, v43, v47, s[62:63]
    ds_write_b128 v11, v[40:43] offset:32768
    v_cndmask_b32 v48, v48, v52, s[62:63]
    v_cndmask_b32 v49, v49, v53, s[62:63]
    v_cndmask_b32 v50, v50, v54, s[62:63]
    v_cndmask_b32 v51, v51, v55, s[62:63]
    ds_write_b128 v11, v[48:51] offset:33792
    s_mov_b64 exec, 1
    ds_add_u32 v13, v14
    s_mov_b64 exec, -1
    s_add_u32 s15, s14, 131072
    s_waitcnt vmcnt(4)
    ds_read_b128 v[128:131], v84 offset:0
    ds_read_b128 v[132:135], v85 offset:0
    ds_read_b128 v[136:139], v86 offset:0
    ds_read_b128 v[140:143], v87 offset:0
    s_add_u32 m0, s100, 8192
    s_waitcnt vmcnt(2)
    buffer_load_dwordx4 v80, s[28:31], s15 offen offset:0 nt lds
    s_waitcnt vmcnt(2)
    buffer_load_dwordx4 v81, s[28:31], s15 offen offset:1024 nt lds
    s_waitcnt vmcnt(2)
    buffer_load_dwordx4 v82, s[28:31], s15 offen offset:2048 nt lds
    s_cmp_lg_u32 s13, 2
    s_cbranch_scc1 L_2
    s_mov_b32 s19, 1600000
L_ppoll:
    ds_read_b32 v12, v13
    s_sub_u32 s19, s19, 1
    s_waitcnt lgkmcnt(0)
    v_readfirstlane_b32 s23, v12
    s_cmp_ge_u32 s23, 8
    s_cbranch_scc1 L_ppoll_ok
    s_cmp_lg_u32 s19, 0
    s_cbranch_scc1 L_ppoll
L_ppoll_ok:
    ds_read_b128 v[16:19], v5 offset:32768
    ds_read_b128 v[20:23], v5 offset:33792
    ds_read_b128 v[24:27], v5 offset:34816
    ds_read_b128 v[28:31], v5 offset:35840
    ds_read_b128 v[32:35], v5 offset:36864
    ds_read_b128 v[36:39], v5 offset:37888
    ds_read_b128 v[40:43], v5 offset:38912
    ds_read_b128 v[44:47], v5 offset:39936
    ds_read_b128 v[48:51], v5 offset:40960
    ds_read_b128 v[52:55], v5 offset:41984
    ds_read_b128 v[56:59], v5 offset:43008
    ds_read_b128 v[60:63], v5 offset:44032
    ds_read_b128 v[64:67], v5 offset:45056
    ds_read_b128 v[68:71], v5 offset:46080
    ds_read_b128 v[72:75], v5 offset:47104
    ds_read_b128 v[76:79], v5 offset:48128
    s_lshl_b32 s22, s8, 8
    s_add_u32 s22, s22, s98
    s_waitcnt lgkmcnt(0)
    v_add_f32 v16, v16, v48
    v_add_f32 v17, v17, v49
    v_add_f32 v18, v18, v50
    v_add_f32 v19, v19, v51
    v_add_f32 v20, v20, v52
    v_add_f32 v21, v21, v53
    v_add_f32 v22, v22, v54
    v_add_f32 v23, v23, v55
    v_add_f32 v24, v24, v56
    v_add_f32 v25, v25, v57
    v_add_f32 v26, v26, v58
    v_add_f32 v27, v27, v59
    v_add_f32 v28, v28, v60
    v_add_f32 v29, v29, v61
    v_add_f32 v30, v30, v62
    v_add_f32 v31, v31, v63
    v_add_f32 v32, v32, v64
    v_add_f32 v33, v33, v65
    v_add_f32 v34, v34, v66
    v_add_f32 v35, v35, v67
    v_add_f32 v36, v36, v68
    v_add_f32 v37, v37, v69
    v_add_f32 v38, v38, v70
    v_add_f32 v39, v39, v71
    v_add_f32 v40, v40, v72
    v_add_f32 v41, v41, v73
    v_add_f32 v42, v42, v74
    v_add_f32 v43, v43, v75
    v_add_f32 v44, v44, v76
    v_add_f32 v45, v45, v77
    v_add_f32 v46, v46, v78
    v_add_f32 v47, v47, v79
    v_add_f32 v16, v16, v32
    v_add_f32 v17, v17, v33
    v_add_f32 v18, v18, v34
    v_add_f32 v19, v19, v35
    v_add_f32 v20, v20, v36
    v_add_f32 v21, v21, v37
    v_add_f32 v22, v22, v38
    v_add_f32 v23, v23, v39
    v_add_f32 v24, v24, v40
    v_add_f32 v25, v25, v41
    v_add_f32 v26, v26, v42
    v_add_f32 v27, v27, v43
    v_add_f32 v28, v28, v44
    v_add_f32 v29, v29, v45
    v_add_f32 v30, v30, v46
    v_add_f32 v31, v31, v47
    v_add_f32 v16, v16, v24
    v_add_f32 v17, v17, v25
    v_add_f32 v18, v18, v26
    v_add_f32 v19, v19, v27
    v_add_f32 v20, v20, v28
    v_add_f32 v21, v21, v29
    v_add_f32 v22, v22, v30
    v_add_f32 v23, v23, v31
    buffer_store_dwordx4 v[16:19], v4, s[48:51], s22 offen offset:0
    ds_write_b128 v5, v[16:19] offset:50688
    buffer_store_dwordx4 v[20:23], v4, s[48:51], s22 offen offset:128
    ds_write_b128 v5, v[20:23] offset:51712
    s_waitcnt vmcnt(4)
    buffer_load_dwordx4 v83, s[28:31], s15 offen offset:3072 nt lds
    s_add_u32 s15, s14, 196608
    s_waitcnt lgkmcnt(0)
    s_waitcnt vmcnt(6)
    ds_read_b128 v[144:147], v84 offset:4096
    ds_read_b128 v[148:151], v85 offset:4096
    ds_read_b128 v[152:155], v86 offset:4096
    ds_read_b128 v[156:159], v87 offset:4096
    s_mov_b32 m0, s100
    s_waitcnt vmcnt(4)
    buffer_load_dwordx4 v80, s[28:31], s15 offen offset:0 nt lds
    s_waitcnt vmcnt(4)
    buffer_load_dwordx4 v81, s[28:31], s15 offen offset:1024 nt lds
    s_branch L_join14
L_2:
    s_waitcnt vmcnt(2)
    buffer_load_dwordx4 v83, s[28:31], s15 offen offset:3072 nt lds
    s_add_u32 s15, s14, 196608
    s_waitcnt lgkmcnt(0)
    s_waitcnt vmcnt(4)
    ds_read_b128 v[144:147], v84 offset:4096
    ds_read_b128 v[148:151], v85 offset:4096
    ds_read_b128 v[152:155], v86 offset:4096
    ds_read_b128 v[156:159], v87 offset:4096
    s_mov_b32 m0, s100
    s_waitcnt vmcnt(2)
    buffer_load_dwordx4 v80, s[28:31], s15 offen offset:0 nt lds
    s_waitcnt vmcnt(2)
    buffer_load_dwordx4 v81, s[28:31], s15 offen offset:1024 nt lds
L_join14:
    s_waitcnt vmcnt(2)
    buffer_load_dwordx4 v82, s[28:31], s15 offen offset:2048 nt lds
    s_cmp_lg_u32 s13, 2
    s_cbranch_scc1 L_3
    s_xor_b32 s22, s7, s11
    v_mov_b32 v8, s6
    v_mov_b32 v9, s22
    s_lshl_b32 s23, s3, 4
    s_add_u32 s23, s23, s8
    s_lshl_b32 s23, s23, 3
    s_add_u32 s23, s23, 3145728
    s_waitcnt vmcnt(4) lgkmcnt(0)
    s_mov_b64 exec, 1
    buffer_store_dwordx2 v[8:9], off, s[48:51], s23 sc1
    s_mov_b64 exec, -1
    s_waitcnt vmcnt(3)
    buffer_load_dwordx4 v83, s[28:31], s15 offen offset:3072 nt lds
    s_add_u32 s15, s14, 262144
    s_waitcnt lgkmcnt(0)
    s_waitcnt vmcnt(5)
    ds_read_b128 v[160:163], v84 offset:8192
    ds_read_b128 v[164:167], v85 offset:8192
    ds_read_b128 v[168:171], v86 offset:8192
    ds_read_b128 v[172:175], v87 offset:8192
    s_add_u32 m0, s100, 4096
    s_waitcnt vmcnt(3)
    buffer_load_dwordx4 v80, s[28:31], s15 offen offset:0 nt lds
    s_waitcnt vmcnt(3)
    buffer_load_dwordx4 v81, s[28:31], s15 offen offset:1024 nt lds
    s_branch L_join18
L_3:
    s_waitcnt vmcnt(2)
    buffer_load_dwordx4 v83, s[28:31], s15 offen offset:3072 nt lds
    s_add_u32 s15, s14, 262144
    s_waitcnt lgkmcnt(0)
    s_waitcnt vmcnt(4)
    ds_read_b128 v[160:163], v84 offset:8192
    ds_read_b128 v[164:167], v85 offset:8192
    ds_read_b128 v[168:171], v86 offset:8192
    ds_read_b128 v[172:175], v87 offset:8192
    s_add_u32 m0, s100, 4096
    s_waitcnt vmcnt(2)
    buffer_load_dwordx4 v80, s[28:31], s15 offen offset:0 nt lds
    s_waitcnt vmcnt(2)
    buffer_load_dwordx4 v81, s[28:31], s15 offen offset:1024 nt lds
L_join18:
    s_waitcnt vmcnt(2)
    buffer_load_dwordx4 v82, s[28:31], s15 offen offset:2048 nt lds
    s_waitcnt vmcnt(2)
    buffer_load_dwordx4 v83, s[28:31], s15 offen offset:3072 nt lds
    s_add_u32 s15, s14, 327680
    s_waitcnt lgkmcnt(0)
    s_waitcnt vmcnt(4)
    ds_read_b128 v[176:179], v84 offset:0
    ds_read_b128 v[180:183], v85 offset:0
    ds_read_b128 v[184:187], v86 offset:0
    ds_read_b128 v[188:191], v87 offset:0
    s_add_u32 m0, s100, 8192
    s_waitcnt vmcnt(2)
    buffer_load_dwordx4 v80, s[28:31], s15 offen offset:0 nt lds
    s_waitcnt vmcnt(2)
    buffer_load_dwordx4 v81, s[28:31], s15 offen offset:1024 nt lds
    s_waitcnt vmcnt(2)
    buffer_load_dwordx4 v82, s[28:31], s15 offen offset:2048 nt lds
    s_waitcnt vmcnt(2)
    buffer_load_dwordx4 v83, s[28:31], s15 offen offset:3072 nt lds
    s_cmp_lg_u32 s13, 1
    s_cbranch_scc1 L_4
    s_lshl_b32 s25, s3, 7
    s_add_u32 s25, s25, 3145728
    v_lshlrev_b32 v6, 3, v2
    buffer_load_dwordx2 v[8:9], v6, s[48:51], s25 offen sc1
    s_add_u32 s15, s14, 393216
    s_waitcnt lgkmcnt(0)
    s_waitcnt vmcnt(5)
    ds_read_b128 v[192:195], v84 offset:4096
    ds_read_b128 v[196:199], v85 offset:4096
    ds_read_b128 v[200:203], v86 offset:4096
    ds_read_b128 v[204:207], v87 offset:4096
    s_mov_b32 m0, s100
    s_waitcnt vmcnt(3)
    buffer_load_dwordx4 v80, s[28:31], s15 offen offset:0 nt lds
    s_waitcnt vmcnt(3)
    buffer_load_dwordx4 v81, s[28:31], s15 offen offset:1024 nt lds
    s_waitcnt vmcnt(3)
    buffer_load_dwordx4 v82, s[28:31], s15 offen offset:2048 nt lds
    s_branch L_join27
L_4:
    s_add_u32 s15, s14, 393216
    s_waitcnt lgkmcnt(0)
    s_waitcnt vmcnt(4)
    ds_read_b128 v[192:195], v84 offset:4096
    ds_read_b128 v[196:199], v85 offset:4096
    ds_read_b128 v[200:203], v86 offset:4096
    ds_read_b128 v[204:207], v87 offset:4096
    s_mov_b32 m0, s100
    s_waitcnt vmcnt(2)
    buffer_load_dwordx4 v80, s[28:31], s15 offen offset:0 nt lds
    s_waitcnt vmcnt(2)
    buffer_load_dwordx4 v81, s[28:31], s15 offen offset:1024 nt lds
    s_waitcnt vmcnt(2)
    buffer_load_dwordx4 v82, s[28:31], s15 offen offset:2048 nt lds
L_join27:
    s_waitcnt vmcnt(2)
    buffer_load_dwordx4 v83, s[28:31], s15 offen offset:3072 nt lds
    s_cmp_lg_u32 s13, 1
    s_cbranch_scc1 L_5
    s_waitcnt vmcnt(4)
    s_mov_b32 s19, 200000
L_fpoll:
    v_xor_b32 v8, s6, v8
    v_xor_b32 v9, s7, v9
    v_lshrrev_b32 v12, 3, v9
    v_or_b32 v8, v8, v12
    v_cmp_ne_u32 vcc, 0, v8
    s_cbranch_vccz L_fok
    s_sub_u32 s19, s19, 1
    s_cmp_eq_u32 s19, 0
    s_cbranch_scc1 L_fok
    s_sleep 16
    buffer_load_dwordx2 v[8:9], v6, s[48:51], s25 offen sc1
    s_waitcnt vmcnt(0)
    s_branch L_fpoll
L_fok:
    v_cmp_ne_u32 vcc, s11, v9
    s_lshl_b32 s25, s9, 12
    s_add_u32 s25, s25, s98
    s_cbranch_vccnz L_slow
    buffer_load_dwordx4 v[96:99], v5, s[48:51], s25 offen offset:0 nt
    buffer_load_dwordx4 v[100:103], v5, s[48:51], s25 offen offset:1024 nt
    buffer_load_dwordx4 v[104:107], v5, s[48:51], s25 offen offset:2048 nt
    buffer_load_dwordx4 v[108:111], v5, s[48:51], s25 offen offset:3072 nt
L_modeok:
    s_add_u32 s15, s14, 458752
    s_waitcnt lgkmcnt(0)
    s_waitcnt vmcnt(8)
    ds_read_b128 v[208:211], v84 offset:8192
    ds_read_b128 v[212:215], v85 offset:8192
    ds_read_b128 v[216:219], v86 offset:8192
    ds_read_b128 v[220:223], v87 offset:8192
    s_add_u32 m0, s100, 4096
    s_waitcnt vmcnt(6)
    buffer_load_dwordx4 v80, s[28:31], s15 offen offset:0 nt lds
    s_waitcnt vmcnt(6)
    buffer_load_dwordx4 v81, s[28:31], s15 offen offset:1024 nt lds
    s_waitcnt vmcnt(6)
    buffer_load_dwordx4 v82, s[28:31], s15 offen offset:2048 nt lds
    s_branch L_join31
L_5:
    s_add_u32 s15, s14, 458752
    s_waitcnt lgkmcnt(0)
    s_waitcnt vmcnt(4)
    ds_read_b128 v[208:211], v84 offset:8192
    ds_read_b128 v[212:215], v85 offset:8192
    ds_read_b128 v[216:219], v86 offset:8192
    ds_read_b128 v[220:223], v87 offset:8192
    s_add_u32 m0, s100, 4096
    s_waitcnt vmcnt(2)
    buffer_load_dwordx4 v80, s[28:31], s15 offen offset:0 nt lds
    s_waitcnt vmcnt(2)
    buffer_load_dwordx4 v81, s[28:31], s15 offen offset:1024 nt lds
    s_waitcnt vmcnt(2)
    buffer_load_dwordx4 v82, s[28:31], s15 offen offset:2048 nt lds
L_join31:
    s_waitcnt vmcnt(2)
    buffer_load_dwordx4 v83, s[28:31], s15 offen offset:3072 nt lds
    s_cmp_lg_u32 s13, 1
    s_cbranch_scc1 L_6
    v_mov_b32 v12, s12
    v_mov_b32 v13, 50432
    s_waitcnt vmcnt(4)
    v_add_f32 v96, v96, v104
    v_add_f32 v97, v97, v105
    v_add_f32 v98, v98, v106
    v_add_f32 v99, v99, v107
    v_add_f32 v100, v100, v108
    v_add_f32 v101, v101, v109
    v_add_f32 v102, v102, v110
    v_add_f32 v103, v103, v111
    v_cvt_pk_bf16_f32 v8, v96, v97
    v_cvt_pk_bf16_f32 v9, v98, v99
    v_cvt_pk_bf16_f32 v10, v100, v101
    v_cvt_pk_bf16_f32 v11, v102, v103
    v_lshlrev_b32 v14, 3, v1
    ds_write_b64 v14, v[8:9] offset:49152
    ds_write_b64 v14, v[10:11] offset:49664
    ds_write_b32 v13, v12
L_6:
    s_mov_b32 s15, s14
    s_waitcnt vmcnt(4)
    ds_read_b128 v[224:227], v84 offset:0
    ds_read_b128 v[228:231], v85 offset:0
    ds_read_b128 v[232:235], v86 offset:0
    ds_read_b128 v[236:239], v87 offset:0
    s_waitcnt vmcnt(2)
    buffer_load_dwordx4 v[16:19], v5, s[32:35], s15 offen offset:0 nt
    s_waitcnt vmcnt(2)
    buffer_load_dwordx4 v[20:23], v5, s[32:35], s15 offen offset:1024 nt
    s_waitcnt vmcnt(2)
    buffer_load_dwordx4 v[24:27], v5, s[32:35], s15 offen offset:2048 nt
    s_waitcnt vmcnt(2)
    buffer_load_dwordx4 v[28:31], v5, s[32:35], s15 offen offset:3072 nt
    s_add_u32 s15, s14, 65536
    s_waitcnt vmcnt(4)
    ds_read_b128 v[240:243], v84 offset:4096
    ds_read_b128 v[244:247], v85 offset:4096
    ds_read_b128 v[248:251], v86 offset:4096
    ds_read_b128 v[252:255], v87 offset:4096
    s_waitcnt vmcnt(2)
    buffer_load_dwordx4 v[32:35], v5, s[32:35], s15 offen offset:0 nt
    s_waitcnt vmcnt(2)
    buffer_load_dwordx4 v[36:39], v5, s[32:35], s15 offen offset:1024 nt
    s_waitcnt vmcnt(2)
    buffer_load_dwordx4 v[40:43], v5, s[32:35], s15 offen offset:2048 nt
    s_waitcnt vmcnt(2)
    buffer_load_dwordx4 v[44:47], v5, s[32:35], s15 offen offset:3072 nt
    s_add_u32 s15, s14, 131072
    s_waitcnt vmcnt(2)
    buffer_load_dwordx4 v[48:51], v5, s[32:35], s15 offen offset:0 nt
    s_waitcnt vmcnt(2)
    buffer_load_dwordx4 v[52:55], v5, s[32:35], s15 offen offset:1024 nt
    s_waitcnt vmcnt(2)
    buffer_load_dwordx4 v[56:59], v5, s[32:35], s15 offen offset:2048 nt
    s_waitcnt vmcnt(2)
    buffer_load_dwordx4 v[60:63], v5, s[32:35], s15 offen offset:3072 nt
    s_add_u32 s15, s14, 196608
    s_waitcnt vmcnt(2)
    buffer_load_dwordx4 v[64:67], v5, s[32:35], s15 offen offset:0 nt
    s_waitcnt vmcnt(2)
    buffer_load_dwordx4 v[68:71], v5, s[32:35], s15 offen offset:1024 nt
    s_waitcnt vmcnt(2)
    buffer_load_dwordx4 v[72:75], v5, s[32:35], s15 offen offset:2048 nt
    s_waitcnt vmcnt(2)
    buffer_load_dwordx4 v[76:79], v5, s[32:35], s15 offen offset:3072 nt
    v_mov_b32 v13, 50432
    v_lshrrev_b32 v14, 2, v2
    v_lshlrev_b32 v14, 8, v14
    v_lshl_or_b32 v14, v3, 4, v14
    s_mov_b32 s19, 1600000
L_qpoll:
    ds_read_b32 v12, v13
    s_sub_u32 s19, s19, 1
    s_waitcnt lgkmcnt(0)
    v_readfirstlane_b32 s12, v12
    s_cmp_ge_u32 s12, 1
    s_cbranch_scc1 L_qpoll_ok
    s_sleep 2
    s_cmp_lg_u32 s19, 0
    s_cbranch_scc1 L_qpoll
L_qpoll_ok:
    s_cmp_eq_u32 s12, 3
    s_cselect_b32 s22, 0, 1048576
    s_add_u32 s98, s98, s22
    ds_read_b128 v[80:83], v14 offset:49152
    ds_read_b128 v[84:87], v14 offset:49216
    ds_read_b128 v[88:91], v14 offset:49280
    ds_read_b128 v[92:95], v14 offset:49344
    s_waitcnt lgkmcnt(0)
    v_mfma_f32_16x16x32_bf16 v[96:99], v[128:131], v[80:83], 0
    v_mfma_f32_16x16x32_bf16 v[96:99], v[132:135], v[84:87], v[96:99]
    v_mfma_f32_16x16x32_bf16 v[96:99], v[136:139], v[88:91], v[96:99]
    v_mfma_f32_16x16x32_bf16 v[96:99], v[140:143], v[92:95], v[96:99]
    s_add_u32 s15, s14, 262144
    s_waitcnt vmcnt(3)
    buffer_load_dwordx4 v[128:131], v5, s[32:35], s15 offen offset:0 nt
    v_mfma_f32_16x16x32_bf16 v[100:103], v[144:147], v[80:83], 0
    v_mfma_f32_16x16x32_bf16 v[100:103], v[148:151], v[84:87], v[100:103]
    v_mfma_f32_16x16x32_bf16 v[100:103], v[152:155], v[88:91], v[100:103]
    v_mfma_f32_16x16x32_bf16 v[100:103], v[156:159], v[92:95], v[100:103]
    v_mfma_f32_16x16x32_bf16 v[104:107], v[160:163], v[80:83], 0
    v_mfma_f32_16x16x32_bf16 v[104:107], v[164:167], v[84:87], v[104:107]
    v_mfma_f32_16x16x32_bf16 v[104:107], v[168:171], v[88:91], v[104:107]
    v_mfma_f32_16x16x32_bf16 v[104:107], v[172:175], v[92:95], v[104:107]
    s_waitcnt vmcnt(3)
    buffer_load_dwordx4 v[132:135], v5, s[32:35], s15 offen offset:1024 nt
    v_mfma_f32_16x16x32_bf16 v[108:111], v[176:179], v[80:83], 0
    v_mfma_f32_16x16x32_bf16 v[108:111], v[180:183], v[84:87], v[108:111]
    v_mfma_f32_16x16x32_bf16 v[108:111], v[184:187], v[88:91], v[108:111]
    v_mfma_f32_16x16x32_bf16 v[108:111], v[188:191], v[92:95], v[108:111]
    v_mfma_f32_16x16x32_bf16 v[112:115], v[192:195], v[80:83], 0
    v_mfma_f32_16x16x32_bf16 v[112:115], v[196:199], v[84:87], v[112:115]
    v_mfma_f32_16x16x32_bf16 v[112:115], v[200:203], v[88:91], v[112:115]
    v_mfma_f32_16x16x32_bf16 v[112:115], v[204:207], v[92:95], v[112:115]
    s_waitcnt vmcnt(3)
    buffer_load_dwordx4 v[136:139], v5, s[32:35], s15 offen offset:2048 nt
    v_mfma_f32_16x16x32_bf16 v[116:119], v[208:211], v[80:83], 0
    v_mfma_f32_16x16x32_bf16 v[116:119], v[212:215], v[84:87], v[116:119]
    v_mfma_f32_16x16x32_bf16 v[116:119], v[216:219], v[88:91], v[116:119]
    v_mfma_f32_16x16x32_bf16 v[116:119], v[220:223], v[92:95], v[116:119]
    v_mfma_f32_16x16x32_bf16 v[120:123], v[224:227], v[80:83], 0
    v_mfma_f32_16x16x32_bf16 v[120:123], v[228:231], v[84:87], v[120:123]
    v_mfma_f32_16x16x32_bf16 v[120:123], v[232:235], v[88:91], v[120:123]
    v_mfma_f32_16x16x32_bf16 v[120:123], v[236:239], v[92:95], v[120:123]
    s_waitcnt vmcnt(3)
    buffer_load_dwordx4 v[140:143], v5, s[32:35], s15 offen offset:3072 nt
    v_mfma_f32_16x16x32_bf16 v[124:127], v[240:243], v[80:83], 0
    v_mfma_f32_16x16x32_bf16 v[124:127], v[244:247], v[84:87], v[124:127]
    v_mfma_f32_16x16x32_bf16 v[124:127], v[248:251], v[88:91], v[124:127]
    v_mfma_f32_16x16x32_bf16 v[124:127], v[252:255], v[92:95], v[124:127]
    s_nop 7
    v_max3_f32 v8, v96, v97, v98
    v_max3_f32 v9, v99, v100, v101
    v_max3_f32 v8, v8, v102, v103
    v_max3_f32 v9, v9, v104, v105
    v_max3_f32 v8, v8, v106, v107
    v_max3_f32 v9, v9, v108, v109
    v_max3_f32 v8, v8, v110, v111
    v_max3_f32 v9, v9, v112, v113
    v_max3_f32 v8, v8, v114, v115
    v_max3_f32 v9, v9, v116, v117
    v_max3_f32 v8, v8, v118, v119
    v_max3_f32 v9, v9, v120, v121
    v_max3_f32 v8, v8, v122, v123
    v_max3_f32 v9, v9, v124, v125
    s_add_u32 s15, s14, 327680
    s_waitcnt vmcnt(3)
    buffer_load_dwordx4 v[144:147], v5, s[32:35], s15 offen offset:0 nt
    v_max3_f32 v8, v8, v126, v127
    v_max_f32 v8, v8, v9
    v_mov_b32 v9, v8
    s_nop 1
    v_permlane32_swap_b32 v8, v9
    s_nop 1
    v_max_f32 v8, v8, v9
    v_mov_b32 v9, v8
    s_nop 1
    v_permlane16_swap_b32 v8, v9
    s_nop 1
    v_max_f32 v8, v8, v9
    v_mul_f32 v8, s18, v8
    v_fma_f32 v96, v96, s18, -v8
    v_fma_f32 v97, v97, s18, -v8
    v_fma_f32 v98, v98, s18, -v8
    v_fma_f32 v99, v99, s18, -v8
    v_fma_f32 v100, v100, s18, -v8
    s_waitcnt vmcnt(3)
    buffer_load_dwordx4 v[148:151], v5, s[32:35], s15 offen offset:1024 nt
    v_fma_f32 v101, v101, s18, -v8
    v_fma_f32 v102, v102, s18, -v8
    v_fma_f32 v103, v103, s18, -v8
    v_fma_f32 v104, v104, s18, -v8
    v_fma_f32 v105, v105, s18, -v8
    v_fma_f32 v106, v106, s18, -v8
    v_fma_f32 v107, v107, s18, -v8
    v_fma_f32 v108, v108, s18, -v8
    v_fma_f32 v109, v109, s18, -v8
    v_fma_f32 v110, v110, s18, -v8
    v_fma_f32 v111, v111, s18, -v8
    v_fma_f32 v112, v112, s18, -v8
    v_fma_f32 v113, v113, s18, -v8
    v_fma_f32 v114, v114, s18, -v8
    s_waitcnt vmcnt(3)
    buffer_load_dwordx4 v[152:155], v5, s[32:35], s15 offen offset:2048 nt
    v_fma_f32 v115, v115, s18, -v8
    v_fma_f32 v116, v116, s18, -v8
    v_fma_f32 v117, v117, s18, -v8
    v_fma_f32 v118, v118, s18, -v8
    v_fma_f32 v119, v119, s18, -v8
    v_fma_f32 v120, v120, s18, -v8
    v_fma_f32 v121, v121, s18, -v8
    v_fma_f32 v122, v122, s18, -v8
    v_fma_f32 v123, v123, s18, -v8
    v_fma_f32 v124, v124, s18, -v8
    v_fma_f32 v125, v125, s18, -v8
    v_fma_f32 v126, v126, s18, -v8
    v_fma_f32 v127, v127, s18, -v8
    v_exp_f32 v96, v96
    s_waitcnt vmcnt(3)
    buffer_load_dwordx4 v[156:159], v5, s[32:35], s15 offen offset:3072 nt
    v_exp_f32 v97, v97
    v_exp_f32 v98, v98
    v_exp_f32 v99, v99
    v_exp_f32 v100, v100
    v_exp_f32 v101, v101
    v_exp_f32 v102, v102
    v_exp_f32 v103, v103
    v_exp_f32 v104, v104
    v_exp_f32 v105, v105
    v_exp_f32 v106, v106
    v_exp_f32 v107, v107
    v_exp_f32 v108, v108
    v_exp_f32 v109, v109
    v_exp_f32 v110, v110
    s_add_u32 s15, s14, 393216
    s_waitcnt vmcnt(3)
    buffer_load_dwordx4 v[160:163], v5, s[32:35], s15 offen offset:0 nt
    s_cmp_lg_u32 s13, 0
    s_cbranch_scc1 L_7
    v_lshlrev_b32 v201, 7, v2
    buffer_load_dword v200, v201, s[48:51], s20 offen sc1
L_7:
    v_exp_f32 v111, v111
    v_exp_f32 v112, v112
    v_exp_f32 v113, v113
    v_exp_f32 v114, v114
    v_exp_f32 v115, v115
    v_exp_f32 v116, v116
    v_exp_f32 v117, v117
    v_exp_f32 v118, v118
    v_exp_f32 v119, v119
    v_exp_f32 v120, v120
    v_exp_f32 v121, v121
    v_exp_f32 v122, v122
    v_exp_f32 v123, v123
    v_exp_f32 v124, v124
    s_waitcnt vmcnt(3)
    buffer_load_dwordx4 v[164:167], v5, s[32:35], s15 offen offset:1024 nt
    v_exp_f32 v125, v125
    v_exp_f32 v126, v126
    v_exp_f32 v127, v127
    v_add_f32 v9, v96, v97
    v_add_f32 v10, v98, v99
    v_add_f32 v11, v100, v101
    v_add_f32 v12, v102, v103
    v_add_f32 v9, v9, v104
    v_add_f32 v10, v10, v105
    v_add_f32 v11, v11, v106
    v_add_f32 v12, v12, v107
    v_add_f32 v9, v9, v108
    v_add_f32 v10, v10, v109
    v_add_f32 v11, v11, v110
    s_waitcnt vmcnt(3)
    buffer_load_dwordx4 v[168:171], v5, s[32:35], s15 offen offset:2048 nt
    v_add_f32 v12, v12, v111
    v_add_f32 v9, v9, v112
    v_add_f32 v10, v10, v113
    v_add_f32 v11, v11, v114
    v_add_f32 v12, v12, v115
    v_add_f32 v9, v9, v116
    v_add_f32 v10, v10, v117
    v_add_f32 v11, v11, v118
    v_add_f32 v12, v12, v119
    v_add_f32 v9, v9, v120
    v_add_f32 v10, v10, v121
    v_add_f32 v11, v11, v122
    v_add_f32 v12, v12, v123
    v_add_f32 v9, v9, v124
    s_waitcnt vmcnt(3)
    buffer_load_dwordx4 v[172:175], v5, s[32:35], s15 offen offset:3072 nt
    v_add_f32 v10, v10, v125
    v_add_f32 v11, v11, v126
    v_add_f32 v12, v12, v127
    v_add_f32 v9, v9, v10
    v_add_f32 v11, v11, v12
    v_add_f32 v9, v9, v11
    v_mov_b32 v10, v9
    s_nop 1
    v_permlane32_swap_b32 v9, v10
    s_nop 1
    v_add_f32 v9, v9, v10
    v_mov_b32 v10, v9
    s_nop 1
    v_permlane16_swap_b32 v9, v10
    s_nop 1
    v_add_f32 v9, v9, v10
    v_lshrrev_b32 v10, 2, v2
    v_lshlrev_b32 v10, 6, v10
    s_add_u32 s15, s14, 458752
    s_waitcnt vmcnt(3)
    buffer_load_dwordx4 v[176:179], v5, s[32:35], s15 offen offset:0 nt
    s_lshl_b32 s22, s13, 3
    v_add_u32 v10, s22, v10
    ds_write_b64 v10, v[8:9] offset:50176
    v_mov_b32 v13, 50440
    v_mov_b32 v14, 1
    s_mov_b64 exec, 1
    ds_add_u32 v13, v14
    s_mov_b64 exec, -1
    v_cvt_pk_bf16_f32 v96, v96, v97
    v_cvt_pk_bf16_f32 v97, v98, v99
    v_cvt_pk_bf16_f32 v98, v100, v101
    v_cvt_pk_bf16_f32 v99, v102, v103
    v_cvt_pk_bf16_f32 v100, v104, v105
    v_cvt_pk_bf16_f32 v101, v106, v107
    v_cvt_pk_bf16_f32 v102, v108, v109
    v_cvt_pk_bf16_f32 v103, v110, v111
    v_cvt_pk_bf16_f32 v104, v112, v113
    v_cvt_pk_bf16_f32 v105, v114, v115
    v_cvt_pk_bf16_f32 v106, v116, v117
    v_cvt_pk_bf16_f32 v107, v118, v119
    v_cvt_pk_bf16_f32 v108, v120, v121
    s_waitcnt vmcnt(3)
    buffer_load_dwordx4 v[180:183], v5, s[32:35], s15 offen offset:1024 nt
    v_cvt_pk_bf16_f32 v109, v122, v123
    v_cvt_pk_bf16_f32 v110, v124, v125
    v_cvt_pk_bf16_f32 v111, v126, v127
    s_waitcnt vmcnt(22)
    v_perm_b32 v80, v20, v16, s16
    v_perm_b32 v81, v28, v24, s16
    v_perm_b32 v82, v36, v32, s16
    v_perm_b32 v83, v44, v40, s16
    v_perm_b32 v84, v20, v16, s17
    v_perm_b32 v85, v28, v24, s17
    v_perm_b32 v86, v36, v32, s17
    v_perm_b32 v87, v44, v40, s17
    v_mfma_f32_16x16x32_bf16 v[224:227], v[96:99], v[80:83], 0
    v_perm_b32 v88, v21, v17, s16
    v_perm_b32 v89, v29, v25, s16
    s_waitcnt vmcnt(3)
    buffer_load_dwordx4 v[184:187], v5, s[32:35], s15 offen offset:2048 nt
    v_perm_b32 v90, v37, v33, s16
    v_perm_b32 v91, v45, v41, s16
    v_mfma_f32_16x16x32_bf16 v[228:231], v[96:99], v[84:87], 0
    v_perm_b32 v92, v21, v17, s17
    v_perm_b32 v93, v29, v25, s17
    v_perm_b32 v94, v37, v33, s17
    v_perm_b32 v95, v45, v41, s17
    v_mfma_f32_16x16x32_bf16 v[232:235], v[96:99], v[88:91], 0
    v_perm_b32 v112, v22, v18, s16
    v_perm_b32 v113, v30, v26, s16
    v_perm_b32 v114, v38, v34, s16
    v_perm_b32 v115, v46, v42, s16
    v_mfma_f32_16x16x32_bf16 v[236:239], v[96:99], v[92:95], 0
    v_perm_b32 v116, v22, v18, s17
    s_waitcnt vmcnt(3)
    buffer_load_dwordx4 v[188:191], v5, s[32:35], s15 offen offset:3072 nt
    v_perm_b32 v117, v30, v26, s17
    v_perm_b32 v118, v38, v34, s17
    v_perm_b32 v119, v46, v42, s17
    v_mfma_f32_16x16x32_bf16 v[240:243], v[96:99], v[112:115], 0
    v_perm_b32 v120, v23, v19, s16
    v_perm_b32 v121, v31, v27, s16
    v_perm_b32 v122, v39, v35, s16
    v_perm_b32 v123, v47, v43, s16
    v_mfma_f32_16x16x32_bf16 v[244:247], v[96:99], v[116:119], 0
    v_perm_b32 v124, v23, v19, s17
    v_perm_b32 v125, v31, v27, s17
    v_perm_b32 v126, v39, v35, s17
    v_perm_b32 v127, v47, v43, s17
    v_mfma_f32_16x16x32_bf16 v[248:251], v[96:99], v[120:123], 0
    s_nop 1
    v_mfma_f32_16x16x32_bf16 v[252:255], v[96:99], v[124:127], 0
    s_waitcnt vmcnt(16)
    v_perm_b32 v80, v52, v48, s16
    v_perm_b32 v81, v60, v56, s16
    v_perm_b32 v82, v68, v64, s16
    v_perm_b32 v83, v76, v72, s16
    v_perm_b32 v84, v52, v48, s17
    v_perm_b32 v85, v60, v56, s17
    v_perm_b32 v86, v68, v64, s17
    v_perm_b32 v87, v76, v72, s17
    v_mfma_f32_16x16x32_bf16 v[224:227], v[100:103], v[80:83], v[224:227]
    v_perm_b32 v88, v53, v49, s16
    v_perm_b32 v89, v61, v57, s16
    v_perm_b32 v90, v69, v65, s16
    v_perm_b32 v91, v77, v73, s16
    v_mfma_f32_16x16x32_bf16 v[228:231], v[100:103], v[84:87], v[228:231]
    v_perm_b32 v92, v53, v49, s17
    v_perm_b32 v93, v61, v57, s17
    v_perm_b32 v94, v69, v65, s17
    v_perm_b32 v95, v77, v73, s17
    v_mfma_f32_16x16x32_bf16 v[232:235], v[100:103], v[88:91], v[232:235]
    v_perm_b32 v112, v54, v50, s16
    v_perm_b32 v113, v62, v58, s16
    v_perm_b32 v114, v70, v66, s16
    v_perm_b32 v115, v78, v74, s16
    v_mfma_f32_16x16x32_bf16 v[236:239], v[100:103], v[92:95], v[236:239]
    v_perm_b32 v116, v54, v50, s17
    v_perm_b32 v117, v62, v58, s17
    v_perm_b32 v118, v70, v66, s17
    v_perm_b32 v119, v78, v74, s17
    v_mfma_f32_16x16x32_bf16 v[240:243], v[100:103], v[112:115], v[240:243]
    v_perm_b32 v120, v55, v51, s16
    v_perm_b32 v121, v63, v59, s16
    v_perm_b32 v122, v71, v67, s16
    v_perm_b32 v123, v79, v75, s16
    v_mfma_f32_16x16x32_bf16 v[244:247], v[100:103], v[116:119], v[244:247]
    v_perm_b32 v124, v55, v51, s17
    v_perm_b32 v125, v63, v59, s17
    v_perm_b32 v126, v71, v67, s17
    v_perm_b32 v127, v79, v75, s17
    v_mfma_f32_16x16x32_bf16 v[248:251], v[100:103], v[120:123], v[248:251]
    s_nop 1
    v_mfma_f32_16x16x32_bf16 v[252:255], v[100:103], v[124:127], v[252:255]
    s_cmp_lt_u32 s13, 4
    s_waitcnt vmcnt(8)
    v_perm_b32 v80, v132, v128, s16
    v_perm_b32 v81, v140, v136, s16
    v_perm_b32 v82, v148, v144, s16
    v_perm_b32 v83, v156, v152, s16
    v_perm_b32 v84, v132, v128, s17
    v_perm_b32 v85, v140, v136, s17
    v_perm_b32 v86, v148, v144, s17
    v_perm_b32 v87, v156, v152, s17
    v_mfma_f32_16x16x32_bf16 v[224:227], v[104:107], v[80:83], v[224:227]
    v_perm_b32 v88, v133, v129, s16
    v_perm_b32 v89, v141, v137, s16
    v_perm_b32 v90, v149, v145, s16
    v_perm_b32 v91, v157, v153, s16
    v_mfma_f32_16x16x32_bf16 v[228:231], v[104:107], v[84:87], v[228:231]
    v_perm_b32 v92, v133, v129, s17
    v_perm_b32 v93, v141, v137, s17
    v_perm_b32 v94, v149, v145, s17
    v_perm_b32 v95, v157, v153, s17
    v_mfma_f32_16x16x32_bf16 v[232:235], v[104:107], v[88:91], v[232:235]
    v_perm_b32 v112, v134, v130, s16
    v_perm_b32 v113, v142, v138, s16
    v_perm_b32 v114, v150, v146, s16
    v_perm_b32 v115, v158, v154, s16
    v_mfma_f32_16x16x32_bf16 v[236:239], v[104:107], v[92:95], v[236:239]
    v_perm_b32 v116, v134, v130, s17
    v_perm_b32 v117, v142, v138, s17
    v_perm_b32 v118, v150, v146, s17
    v_perm_b32 v119, v158, v154, s17
    v_mfma_f32_16x16x32_bf16 v[240:243], v[104:107], v[112:115], v[240:243]
    v_perm_b32 v120, v135, v131, s16
    v_perm_b32 v121, v143, v139, s16
    v_perm_b32 v122, v151, v147, s16
    v_perm_b32 v123, v159, v155, s16
    v_mfma_f32_16x16x32_bf16 v[244:247], v[104:107], v[116:119], v[244:247]
    v_perm_b32 v124, v135, v131, s17
    v_perm_b32 v125, v143, v139, s17
    v_perm_b32 v126, v151, v147, s17
    v_perm_b32 v127, v159, v155, s17
    v_mfma_f32_16x16x32_bf16 v[248:251], v[104:107], v[120:123], v[248:251]
    s_nop 1
    v_mfma_f32_16x16x32_bf16 v[252:255], v[104:107], v[124:127], v[252:255]
    s_sub_u32 s26, s13, 4
    s_lshl_b32 s22, s26, 6
    v_mov_b32 v10, s22
    s_cmp_ge_u32 s13, 4
    s_cbranch_scc1 L_9
    s_lshr_b32 s26, s13, 1
    s_lshl_b32 s22, s10, 1
    s_add_u32 s22, s22, s26
    v_lshlrev_b32 v11, 2, v2
    s_lshl_b32 s23, s22, 6
    s_add_u32 s23, s23, s98
    s_add_u32 s23, s23, 49152
    s_lshl_b32 s27, s22, 12
    s_add_u32 s27, s27, s98
    s_add_u32 s27, s27, 32768
    s_and_b32 s25, s13, 1
    v_and_b32 v14, 1, v3
    v_lshlrev_b32 v14, 3, v14
    v_lshrrev_b32 v12, 1, v3
    v_lshl_or_b32 v14, v12, 2, v14
    v_or_b32 v14, s25, v14
    v_add_u32 v70, 2, v14
    v_add_u32 v12, s21, v14
    v_and_b32 v12, 15, v12
    v_lshlrev_b32 v14, 11, v14
    v_lshl_or_b32 v14, v12, 7, v14
    v_lshl_or_b32 v14, v2, 3, v14
    v_add_u32 v12, s21, v70
    v_and_b32 v12, 15, v12
    v_lshlrev_b32 v70, 11, v70
    v_lshl_or_b32 v70, v12, 7, v70
    v_lshl_or_b32 v70, v2, 3, v70
    v_and_b32 v8, 1, v3
    v_lshlrev_b32 v8, 1, v8
    v_lshrrev_b32 v9, 3, v2
    v_or_b32 v8, v8, v9
    v_lshlrev_b32 v8, 1, v8
    v_bfe_u32 v9, v2, 1, 1
    s_lshl_b32 s22, s25, 2
    v_or_b32 v9, s22, v9
    v_xor_b32 v8, v8, v9
    v_lshlrev_b32 v8, 4, v8
    v_lshrrev_b32 v9, 2, v2
    v_lshl_or_b32 v8, v9, 7, v8
    v_lshl_or_b32 v8, v3, 10, v8
    v_and_b32 v9, 1, v2
    v_lshl_or_b32 v8, v9, 3, v8
    s_lshl_b32 s22, s26, 14
    v_add_u32 v48, s22, v8
    v_xor_b32 v49, 32, v48
    v_lshlrev_b32 v13, 4, v3
    s_lshl_b32 s22, s13, 10
    v_add_u32 v50, s22, v5
    v_xor_b32 v51, 0x800, v50
    s_lshl_b32 s22, s25, 2
    s_add_u32 s22, s22, 50448
    v_mov_b32 v7, s22
    v_mov_b32 v71, 1
    s_or_b32 s22, s7, 1
    v_lshlrev_b32 v6, 1, v2
    v_mul_lo_u32 v6, v6, s22
    v_add_u32 v192, s6, v6
    v_add_u32 v193, s22, v192
    s_movk_i32 s99, 0xff
    s_branch L_8
L_9:
    s_mov_b32 s19, 1600000
L_spoll:
    ds_read_b32 v12, v13
    s_sub_u32 s19, s19, 1
    s_waitcnt lgkmcnt(0)
    v_readfirstlane_b32 s23, v12
    s_cmp_ge_u32 s23, 8
    s_cbranch_scc1 L_spoll_ok
    s_cmp_lg_u32 s19, 0
    s_cbranch_scc1 L_spoll
L_spoll_ok:
    ds_read_b128 v[16:19], v10 offset:50176
    ds_read_b128 v[20:23], v10 offset:50192
    ds_read_b128 v[24:27], v10 offset:50208
    ds_read_b128 v[28:31], v10 offset:50224
    s_lshl_b32 s22, s26, 4
    s_add_u32 s22, s22, s8
    s_lshl_b32 s22, s22, 2
    s_add_u32 s22, s22, s98
    s_add_u32 s22, s22, 49152
    s_waitcnt lgkmcnt(0)
    v_max3_f32 v8, v16, v18, v20
    v_max3_f32 v9, v22, v24, v26
    v_max3_f32 v8, v8, v28, v30
    v_max_f32 v8, v8, v9
    v_sub_f32 v16, v16, v8
    v_sub_f32 v18, v18, v8
    v_sub_f32 v20, v20, v8
    v_sub_f32 v22, v22, v8
    v_sub_f32 v24, v24, v8
    v_sub_f32 v26, v26, v8
    v_sub_f32 v28, v28, v8
    v_sub_f32 v30, v30, v8
    v_exp_f32 v16, v16
    v_exp_f32 v18, v18
    v_exp_f32 v20, v20
    v_exp_f32 v22, v22
    v_exp_f32 v24, v24
    v_exp_f32 v26, v26
    v_exp_f32 v28, v28
    v_exp_f32 v30, v30
    v_mul_f32 v9, v16, v17
    v_fma_f32 v9, v18, v19, v9
    v_fma_f32 v9, v20, v21, v9
    v_fma_f32 v9, v22, v23, v9
    v_fma_f32 v9, v24, v25, v9
    v_fma_f32 v9, v26, v27, v9
    v_fma_f32 v9, v28, v29, v9
    v_fma_f32 v9, v30, v31, v9
    v_rcp_f32 v13, v9
    v_log_f32 v14, v9
    s_nop 0
    v_add_f32 v14, v14, v8
    s_mov_b64 exec, 1
    s_cmp_eq_u32 s12, 3
    s_cbranch_scc0 L_10
    buffer_store_dword v14, off, s[48:51], s22
    s_branch L_11
L_10:
    buffer_store_dword v14, off, s[48:51], s22 sc1
L_11:
    s_mov_b64 exec, -1
    v_mul_f32 v32, v16, v13
    v_mul_f32 v33, v18, v13
    v_mul_f32 v34, v20, v13
    v_mul_f32 v35, v22, v13
    v_mul_f32 v36, v24, v13
    v_mul_f32 v37, v26, v13
    v_mul_f32 v38, v28, v13
    v_mul_f32 v39, v30, v13
    s_lshl_b32 s22, s26, 6
    v_lshlrev_b32 v10, 9, v3
    v_lshl_or_b32 v10, v2, 2, v10
    v_add_u32 v10, s22, v10
    v_lshlrev_b32 v11, 8, v2
    v_lshl_or_b32 v11, v3, 2, v11
    s_lshl_b32 s99, s26, 8
    s_add_u32 s99, s99, s8
    s_lshl_b32 s99, s99, 4
    s_add_u32 s99, s99, s98
    s_add_u32 s99, s99, 32768
L_8:
    s_lshl_b32 s22, s13, 11
    v_lshl_add_u32 v15, v1, 2, s22
    s_cmp_lt_u32 s13, 4
    s_cbranch_scc0 L_12
    s_waitcnt vmcnt(6)
L_12:
    s_waitcnt vmcnt(7)
    v_perm_b32 v80, v164, v160, s16
    v_perm_b32 v84, v164, v160, s17
    v_perm_b32 v88, v165, v161, s16
    v_perm_b32 v92, v165, v161, s17
    v_perm_b32 v112, v166, v162, s16
    v_perm_b32 v116, v166, v162, s17
    v_perm_b32 v120, v167, v163, s16
    v_perm_b32 v124, v167, v163, s17
    s_cbranch_scc0 L_13
    s_waitcnt vmcnt(4)
L_13:
    s_waitcnt vmcnt(5)
    v_perm_b32 v81, v172, v168, s16
    v_perm_b32 v85, v172, v168, s17
    v_perm_b32 v89, v173, v169, s16
    v_perm_b32 v93, v173, v169, s17
    v_perm_b32 v113, v174, v170, s16
    v_perm_b32 v117, v174, v170, s17
    v_perm_b32 v121, v175, v171, s16
    v_perm_b32 v125, v175, v171, s17
    s_cbranch_scc0 L_14
    s_waitcnt vmcnt(2)
L_14:
    s_waitcnt vmcnt(3)
    v_perm_b32 v82, v180, v176, s16
    v_perm_b32 v86, v180, v176, s17
    v_perm_b32 v90, v181, v177, s16
    v_perm_b32 v94, v181, v177, s17
    v_perm_b32 v114, v182, v178, s16
    v_perm_b32 v118, v182, v178, s17
    v_perm_b32 v122, v183, v179, s16
    v_perm_b32 v126, v183, v179, s17
    s_cbranch_scc0 L_15
    s_waitcnt vmcnt(0)
L_15:
    s_waitcnt vmcnt(1)
    v_perm_b32 v83, v188, v184, s16
    v_perm_b32 v87, v188, v184, s17
    v_perm_b32 v91, v189, v185, s16
    v_mfma_f32_16x16x32_bf16 v[224:227], v[108:111], v[80:83], v[224:227]
    v_perm_b32 v95, v189, v185, s17
    v_mfma_f32_16x16x32_bf16 v[228:231], v[108:111], v[84:87], v[228:231]
    v_perm_b32 v115, v190, v186, s16
    v_mfma_f32_16x16x32_bf16 v[232:235], v[108:111], v[88:91], v[232:235]
    v_perm_b32 v119, v190, v186, s17
    v_mfma_f32_16x16x32_bf16 v[236:239], v[108:111], v[92:95], v[236:239]
    v_perm_b32 v123, v191, v187, s16
    v_mfma_f32_16x16x32_bf16 v[240:243], v[108:111], v[112:115], v[240:243]
    v_perm_b32 v127, v191, v187, s17
    v_mfma_f32_16x16x32_bf16 v[244:247], v[108:111], v[116:119], v[244:247]
    v_mfma_f32_16x16x32_bf16 v[248:251], v[108:111], v[120:123], v[248:251]
    v_mfma_f32_16x16x32_bf16 v[252:255], v[108:111], v[124:127], v[252:255]
    s_nop 1
    ds_write2st64_b32 v15, v224, v228 offset0:128 offset1:129
    ds_write2st64_b32 v15, v232, v236 offset0:130 offset1:131
    s_nop 1
    ds_write2st64_b32 v15, v240, v244 offset0:132 offset1:133
    s_nop 0
    ds_write2st64_b32 v15, v248, v252 offset0:134 offset1:135
    s_cbranch_scc0 L_16
    v_mov_b32 v202, v7
    s_mov_b32 s62, s23
    v_and_b32 v6, 1, v3
    v_lshlrev_b32 v6, 1, v6
    v_and_b32 v7, 7, v1
    v_xor_b32 v6, v6, v7
    v_lshlrev_b32 v6, 4, v6
    v_lshrrev_b32 v7, 3, v1
    v_lshl_or_b32 v6, v7, 10, v6
    v_xor_b32 v7, 64, v6
    s_and_b32 s22, s13, 3
    s_lshl_b32 s23, s22, 13
    s_lshl_b32 s60, s21, 2
    s_add_u32 s60, s60, s22
    s_lshl_b32 s60, s60, 16
    s_lshl_b32 s22, s101, 7
    s_add_u32 s60, s60, s22
    s_cmp_ge_u32 s13, 4
    s_cbranch_scc1 L_17
    s_add_u32 m0, s23, 0
    s_add_u32 s22, s60, 0
    buffer_load_dwordx4 v6, s[40:43], s22 offen nt lds
    s_add_u32 m0, s23, 1024
    s_add_u32 s22, s60, 8192
    buffer_load_dwordx4 v7, s[40:43], s22 offen nt lds
    s_add_u32 m0, s23, 2048
    s_add_u32 s22, s60, 16384
    buffer_load_dwordx4 v6, s[40:43], s22 offen nt lds
    s_add_u32 m0, s23, 3072
    s_add_u32 s22, s60, 24576
    buffer_load_dwordx4 v7, s[40:43], s22 offen nt lds
    s_add_u32 m0, s23, 4096
    s_add_u32 s22, s60, 32768
    buffer_load_dwordx4 v6, s[40:43], s22 offen nt lds
    s_add_u32 m0, s23, 5120
    s_add_u32 s22, s60, 40960
    buffer_load_dwordx4 v7, s[40:43], s22 offen nt lds
    s_add_u32 m0, s23, 6144
    s_add_u32 s22, s60, 49152
    buffer_load_dwordx4 v6, s[40:43], s22 offen nt lds
    s_add_u32 m0, s23, 7168
    s_add_u32 s22, s60, 57344
    buffer_load_dwordx4 v7, s[40:43], s22 offen nt lds
    s_branch L_18
L_17:
L_18:
    v_mov_b32 v7, v202
    s_mov_b32 s23, s62
    s_cmp_lt_u32 s13, 4
L_16:
    s_waitcnt lgkmcnt(0)
    s_barrier
    s_cbranch_scc1 L_proj
    ds_read2st64_b32 v[16:17], v10 offset0:128 offset1:129
    ds_read2st64_b32 v[18:19], v10 offset0:136 offset1:137
    ds_read2st64_b32 v[20:21], v10 offset0:144 offset1:145
    ds_read2st64_b32 v[22:23], v10 offset0:152 offset1:153
    ds_read2st64_b32 v[24:25], v10 offset0:160 offset1:161
    ds_read2st64_b32 v[26:27], v10 offset0:168 offset1:169
    ds_read2st64_b32 v[28:29], v10 offset0:176 offset1:177
    ds_read2st64_b32 v[30:31], v10 offset0:184 offset1:185
    s_cmp_eq_u32 s12, 3
    s_waitcnt lgkmcnt(6)
    v_mul_f32 v8, v32, v16
    v_mul_f32 v9, v32, v17
    v_mul_f32 v12, v33, v18
    v_mul_f32 v13, v33, v19
    s_waitcnt lgkmcnt(4)
    v_fma_f32 v8, v34, v20, v8
    v_fma_f32 v9, v34, v21, v9
    v_fma_f32 v12, v35, v22, v12
    v_fma_f32 v13, v35, v23, v13
    s_waitcnt lgkmcnt(2)
    v_fma_f32 v8, v36, v24, v8
    v_fma_f32 v9, v36, v25, v9
    v_fma_f32 v12, v37, v26, v12
    v_fma_f32 v13, v37, v27, v13
    s_waitcnt lgkmcnt(0)
    v_fma_f32 v8, v38, v28, v8
    v_fma_f32 v9, v38, v29, v9
    v_fma_f32 v12, v39, v30, v12
    v_fma_f32 v13, v39, v31, v13
    v_add_f32 v8, v8, v12
    v_add_f32 v9, v9, v13
    v_cvt_pk_bf16_f32 v8, v8, v9
    s_cbranch_scc0 L_19
    buffer_store_dword v8, v11, s[48:51], s99 offen
    s_branch L_20
L_19:
    buffer_store_dword v8, v11, s[48:51], s99 offen sc1
L_20:
    s_waitcnt vmcnt(1)
    s_barrier
    s_cmp_lg_u32 s13, 4
    s_cbranch_scc1 L_fin
    v_and_b32 v10, 7, v1
    v_lshlrev_b32 v10, 2, v10
    s_or_b32 s22, s7, 1
    v_mul_lo_u32 v40, v10, s22
    v_add_u32 v40, s6, v40
    v_add_u32 v41, s22, v40
    v_add_u32 v42, s22, v41
    v_add_u32 v43, s22, v42
    v_lshrrev_b32 v12, 1, v3
    v_lshl_or_b32 v10, v12, 1, v10
    v_and_b32 v12, 1, v3
    v_lshl_or_b32 v10, v12, 5, v10
    s_lshl_b32 s25, s5, 11
    s_lshl_b32 s24, s4, 10
    s_add_u32 s25, s25, s24
    s_lshl_b32 s24, s101, 7
    s_add_u32 s25, s25, s24
    s_lshl_b32 s24, s10, 6
    s_add_u32 s25, s25, s24
    s_lshl_b32 s24, s10, 2
    s_add_u32 s24, s24, 50448
    v_mov_b32 v13, s24
    s_movk_i32 s26, 0xff00
    s_mov_b32 s62, 0x01010101
    s_mov_b32 s19, 1600000
L_rpoll:
    ds_read_b32 v12, v13
    s_sub_u32 s19, s19, 1
    s_waitcnt lgkmcnt(0)
    v_readfirstlane_b32 s23, v12
    s_cmp_ge_u32 s23, 2
    s_cbranch_scc1 L_rpoll_ok
    s_sleep 1
    s_cmp_lg_u32 s19, 0
    s_cbranch_scc1 L_rpoll
L_rpoll_ok:
    s_mov_b32 s19, 200000
    v_not_b32 v16, v40
    v_not_b32 v20, v40
L_poll2:
    v_xor_b32 v32, v40, v16
    v_xor_b32 v33, v41, v17
    v_xor_b32 v34, v42, v18
    v_xor_b32 v35, v43, v19
    v_xor_b32 v36, v40, v20
    v_xor_b32 v37, v41, v21
    v_xor_b32 v38, v42, v22
    v_xor_b32 v39, v43, v23
    v_or3_b32 v8, v32, v33, v34
    v_or3_b32 v9, v35, v36, v37
    v_or3_b32 v8, v8, v38, v39
    v_or_b32 v8, v8, v9
    v_and_b32 v8, 0xff, v8
    v_cmp_ne_u32 vcc, 0, v8
    s_cbranch_vccz L_got2
    s_lshr_b64 s[22:23], vcc, 4
    s_or_b64 vcc, vcc, s[22:23]
    s_lshr_b64 s[22:23], vcc, 2
    s_or_b64 vcc, vcc, s[22:23]
    s_lshr_b64 s[22:23], vcc, 1
    s_or_b64 vcc, vcc, s[22:23]
    s_and_b32 s22, vcc_lo, s62
    s_and_b32 s23, vcc_hi, s62
    s_mul_i32 exec_lo, s22, 0xff
    s_mul_i32 exec_hi, s23, 0xff
    buffer_load_dwordx4 v[16:19], v5, s[48:51], s20 offen offset:0 sc1
    buffer_load_dwordx4 v[20:23], v5, s[48:51], s20 offen offset:1024 sc1
    s_sleep 2
    s_sub_u32 s19, s19, 1
    s_cmp_eq_u32 s19, 0
    s_waitcnt vmcnt(4)
    s_cbranch_scc0 L_poll2
L_got2:
    s_mov_b64 exec, -1
    v_and_b32 v32, s26, v16
    v_and_b32 v33, s26, v17
    v_and_b32 v34, s26, v18
    v_and_b32 v35, s26, v19
    v_and_b32 v36, s26, v20
    v_and_b32 v37, s26, v21
    v_and_b32 v38, s26, v22
    v_and_b32 v39, s26, v23
    v_add_f32 v24, v32, v36
    v_add_f32 v25, v33, v37
    v_add_f32 v26, v34, v38
    v_add_f32 v27, v35, v39
    s_nop 0
    v_permlane32_swap_b32 v24, v26
    v_permlane32_swap_b32 v25, v27
    s_nop 0
    v_add_f32 v24, v24, v26
    v_add_f32 v25, v25, v27
    s_nop 1
    v_permlane16_swap_b32 v24, v25
    s_nop 1
    v_add_f32 v24, v24, v25
    s_nop 1
    v_add_f32_dpp v24, v24, v24 row_ror:8 row_mask:0xf bank_mask:0xf
    v_cvt_pk_bf16_f32 v24, v24, v24
    buffer_store_short v24, v10, s[52:55], s25 offen
    s_or_b32 s22, s5, s8
    s_cmp_lg_u32 s22, 0
    s_cbranch_scc1 L_fin
    v_mov_b32 v8, s6
    v_mov_b32 v9, s7
    s_mov_b64 exec, 1
    buffer_store_dwordx2 v[8:9], off, s[48:51], s96
    s_branch L_fin
L_slow:
    s_mov_b32 s12, 1
    s_add_u32 s98, s98, 1048576
    s_add_u32 s25, s25, 1048576
    v_mov_b32 v12, -1
    v_mov_b32 v13, -1
    v_mov_b32 v14, -1
    v_mov_b32 v15, -1
    s_lshl_b32 s22, s8, 10
    s_add_u32 s22, s22, s98
    s_add_u32 s22, s22, 32768
    buffer_store_dwordx4 v[12:15], v5, s[48:51], s22 offen sc1
    s_lshl_b32 s22, s8, 4
    s_add_u32 s22, s22, s98
    s_add_u32 s22, s22, 49152
    s_mov_b64 exec, 1
    buffer_store_dwordx4 v[12:15], off, s[48:51], s22 sc1
    s_mov_b64 exec, -1
    ds_read_b128 v[96:99], v5 offset:50688
    ds_read_b128 v[100:103], v5 offset:51712
    s_lshl_b32 s22, s8, 8
    s_add_u32 s22, s22, s98
    s_sub_u32 s98, s98, 1048576
    s_waitcnt lgkmcnt(0)
    buffer_store_dwordx4 v[96:99], v4, s[48:51], s22 offen offset:0 sc1
    buffer_store_dwordx4 v[100:103], v4, s[48:51], s22 offen offset:128 sc1
    v_mov_b32 v8, 1
    s_lshl_b32 s22, s3, 2
    s_waitcnt vmcnt(0)
    s_mov_b64 exec, 1
    buffer_atomic_add v8, off, s[56:59], s22 sc1
    s_mov_b64 exec, -1
    s_mov_b32 s19, 200000
L_gpoll:
    s_sleep 32
    buffer_load_dword v8, off, s[56:59], s22 sc1
    s_sub_u32 s19, s19, 1
    s_waitcnt vmcnt(0)
    v_readfirstlane_b32 s23, v8
    s_cmp_eq_u32 s19, 0
    s_cbranch_scc1 L_gok
    s_cmp_lt_u32 s23, 16
    s_cbranch_scc1 L_gpoll
L_gok:
    buffer_load_dwordx4 v[96:99], v5, s[48:51], s25 offen offset:0 sc1
    buffer_load_dwordx4 v[100:103], v5, s[48:51], s25 offen offset:1024 sc1
    buffer_load_dwordx4 v[104:107], v5, s[48:51], s25 offen offset:2048 sc1
    buffer_load_dwordx4 v[108:111], v5, s[48:51], s25 offen offset:3072 sc1
    s_branch L_modeok
L_proj:
    s_mov_b32 s19, 200000
    s_waitcnt vmcnt(0)
    s_barrier
    buffer_load_dwordx4 v[52:55], v5, s[48:51], s27 offen offset:0 sc1
    buffer_load_dwordx4 v[56:59], v5, s[48:51], s27 offen offset:1024 sc1
    buffer_load_dwordx4 v[60:63], v5, s[48:51], s27 offen offset:2048 sc1
    buffer_load_dwordx4 v[64:67], v5, s[48:51], s27 offen offset:3072 sc1
    buffer_load_dword v68, v11, s[48:51], s23 offen sc1
    ds_read_b64_tr_b16 v[16:17], v48 offset:0
    ds_read_b64_tr_b16 v[18:19], v48 offset:512
    ds_read_b64_tr_b16 v[20:21], v49 offset:0
    ds_read_b64_tr_b16 v[22:23], v49 offset:512
    ds_read_b64_tr_b16 v[24:25], v48 offset:4096
    ds_read_b64_tr_b16 v[26:27], v48 offset:4608
    ds_read_b64_tr_b16 v[28:29], v49 offset:4096
    ds_read_b64_tr_b16 v[30:31], v49 offset:4608
    ds_read_b64_tr_b16 v[32:33], v48 offset:8192
    ds_read_b64_tr_b16 v[34:35], v48 offset:8704
    ds_read_b64_tr_b16 v[36:37], v49 offset:8192
    ds_read_b64_tr_b16 v[38:39], v49 offset:8704
    ds_read_b64_tr_b16 v[40:41], v48 offset:12288
    ds_read_b64_tr_b16 v[42:43], v48 offset:12800
    ds_read_b64_tr_b16 v[44:45], v49 offset:12288
    ds_read_b64_tr_b16 v[46:47], v49 offset:12800
    s_waitcnt vmcnt(0)
L_poll1:
    v_max3_u32 v8, v52, v53, v54
    v_max3_u32 v9, v55, v56, v57
    v_max3_u32 v8, v8, v58, v59
    v_max3_u32 v9, v9, v60, v61
    v_max3_u32 v8, v8, v62, v63
    v_max3_u32 v9, v9, v64, v65
    v_max3_u32 v8, v8, v66, v67
    v_max3_u32 v8, v8, v9, v68
    v_cmp_eq_u32 vcc, -1, v8
    s_cbranch_vccz L_got1
    s_mov_b64 exec, vcc
    s_sleep 1
    buffer_load_dwordx4 v[52:55], v5, s[48:51], s27 offen offset:0 sc1
    buffer_load_dwordx4 v[56:59], v5, s[48:51], s27 offen offset:1024 sc1
    buffer_load_dwordx4 v[60:63], v5, s[48:51], s27 offen offset:2048 sc1
    buffer_load_dwordx4 v[64:67], v5, s[48:51], s27 offen offset:3072 sc1
    buffer_load_dword v68, v11, s[48:51], s23 offen sc1
    s_sub_u32 s19, s19, 1
    s_cmp_eq_u32 s19, 0
    s_waitcnt vmcnt(0)
    s_cbranch_scc0 L_poll1
L_got1:
    s_mov_b64 exec, -1
    s_waitcnt lgkmcnt(0)
    v_mov_b32 v69, v68
    v_mfma_f32_16x16x32_bf16 v[76:79], v[52:55], v[16:19], 0
    v_mfma_f32_16x16x32_bf16 v[80:83], v[52:55], v[20:23], 0
    v_sub_f32_dpp v69, v69, v68 row_ror:8 row_mask:0xf bank_mask:0xf
    v_mfma_f32_16x16x32_bf16 v[76:79], v[56:59], v[24:27], v[76:79]
    v_exp_f32 v69, v69
    v_mfma_f32_16x16x32_bf16 v[80:83], v[56:59], v[28:31], v[80:83]
    v_add_f32 v69, 1.0, v69
    v_mfma_f32_16x16x32_bf16 v[76:79], v[60:63], v[32:35], v[76:79]
    v_rcp_f32 v69, v69
    v_mfma_f32_16x16x32_bf16 v[80:83], v[60:63], v[36:39], v[80:83]
    ds_bpermute_b32 v72, v13, v69 offset:0
    ds_bpermute_b32 v73, v13, v69 offset:4
    ds_bpermute_b32 v74, v13, v69 offset:8
    ds_bpermute_b32 v75, v13, v69 offset:12
    v_mfma_f32_16x16x32_bf16 v[76:79], v[64:67], v[40:43], v[76:79]
    v_mfma_f32_16x16x32_bf16 v[80:83], v[64:67], v[44:47], v[80:83]
    s_waitcnt lgkmcnt(0)
    s_nop 5
    v_mul_f32 v76, v72, v76
    v_mul_f32 v77, v73, v77
    v_mul_f32 v78, v74, v78
    v_mul_f32 v79, v75, v79
    v_mul_f32 v80, v72, v80
    v_mul_f32 v81, v73, v81
    v_mul_f32 v82, v74, v82
    v_mul_f32 v83, v75, v83
    v_permlane32_swap_b32 v76, v78
    v_permlane32_swap_b32 v77, v79
    s_nop 0
    v_permlane32_swap_b32 v80, v82
    v_permlane32_swap_b32 v81, v83
    s_nop 0
    v_add_f32 v84, v76, v78
    v_add_f32 v85, v80, v82
    v_add_f32 v86, v77, v79
    v_add_f32 v87, v81, v83
    ds_write_b128 v50, v[84:87] offset:50688
    s_mov_b64 exec, 1
    ds_add_rtn_u32 v12, v7, v71
    s_mov_b64 exec, -1
    ds_read_b128 v[88:91], v51 offset:50688
    s_waitcnt lgkmcnt(0)
    v_readfirstlane_b32 s24, v12
    v_add_f32 v88, v88, v84
    v_add_f32 v89, v89, v85
    v_add_f32 v90, v90, v86
    v_add_f32 v91, v91, v87
    s_cmp_lg_u32 s24, 1
    s_cbranch_scc1 L_fin
    v_bfi_b32 v88, s99, v192, v88
    v_bfi_b32 v89, s99, v193, v89
    buffer_store_dwordx2 v[88:89], v14, s[48:51], s97 offen sc1
    v_bfi_b32 v90, s99, v192, v90
    v_bfi_b32 v91, s99, v193, v91
    buffer_store_dwordx2 v[90:91], v70, s[48:51], s97 offen sc1
L_fin:
L_end:
    s_endpgm
.section .rodata,"a"
.p2align 6
.amdhsa_kernel concat_heads__sliding_block_cached__sliding_block_cached__decode_kernel
  .amdhsa_next_free_vgpr 256
  .amdhsa_next_free_sgpr 102
  .amdhsa_accum_offset 256
  .amdhsa_group_segment_fixed_size 0
  .amdhsa_kernarg_size 104
  .amdhsa_user_sgpr_count 2
  .amdhsa_user_sgpr_kernarg_segment_ptr 1
  .amdhsa_system_sgpr_workgroup_id_x 1
.end_amdhsa_kernel
```
